```python
import torch

def _softmax(x, axis=-1):
    return torch.softmax(x, dim=axis)
def _gelu(x):
    return torch.nn.functional.gelu(x, approximate="tanh")
def _silu(x):
    return torch.nn.functional.silu(x)
def _sigmoid(x):
    return torch.sigmoid(x)
def _layernorm(x, axis=-1, eps=1e-5):
    m = x.mean(dim=axis, keepdim=True)
    v = x.var(dim=axis, keepdim=True, unbiased=False)
    return (x - m) / torch.sqrt(v + eps)
def _scatter_add(tgt, idx, src, axis=0):
    return tgt.clone().index_add_(axis, idx, src)
def _segment_sum(src, seg, n):
    out = torch.zeros((n,) + src.shape[1:], dtype=src.dtype)
    return out.index_add_(0, seg, src)
def _pad(x, pw):
    flat = tuple(v for pair in reversed(pw) for v in pair)
    return torch.nn.functional.pad(x, flat)

kernel_name = 'gated_mix__sliding_block_cached__mixer_channel_mlp__decode'

def setup_inputs():

    _w = (lambda a: (lambda t: t.to(torch.bfloat16) if t.is_floating_point() else t)(torch.as_tensor(a)))
    def _A_setup():
        B, Sq, D = 1, 1, 576
        Hq, Hkv, Sk, Dh = 32, 16, 32768, 128
        assert Hq % Hkv == 0, (Hq, Hkv)
        return {
            "x": _w((lambda *s: torch.randn(*s, dtype=torch.bfloat16) * 0.05)(B, Sq, D)),
            "k_cache": _w((lambda *s: torch.randn(*s, dtype=torch.bfloat16) * 6.4)(B, Hkv, Sk, Dh)),
            "v_cache": _w((lambda *s: torch.randn(*s, dtype=torch.bfloat16) * 0.4)(B, Hkv, Sk, Dh)),
            "wq": _w((lambda *s: torch.randn(*s, dtype=torch.bfloat16) * 6.4)(D, Hq * Dh) * (D ** -0.5)),
            "wo": _w((lambda *s: torch.randn(*s, dtype=torch.bfloat16) * 0.4)(Hq * Dh, D) * ((Hq * Dh) ** -0.5)),
        }
    _A_in = _A_setup()

    def _B_setup():
        B, S, D, F = 1, 1, 576, 4608
        return {
            "x": _w((lambda *s: torch.randn(*s, dtype=torch.bfloat16) * 0.05)(B, S, D)),
            "w1": _w((lambda *s: torch.randn(*s, dtype=torch.bfloat16) * 1.6)(D, F) * (D ** -0.5)),
            "b1": _w((lambda *s: torch.randn(*s, dtype=torch.bfloat16) * 0.8)(F)),
            "w2": _w((lambda *s: torch.randn(*s, dtype=torch.bfloat16) * 0.05)(F, D) * (F ** -0.5)),
            "b2": _w((lambda *s: torch.randn(*s, dtype=torch.bfloat16) * 0.05)(D)),
        }
    _B_in = _B_setup()

    return {
        "A_x": _A_in["x"],
        "A_k_cache": _A_in["k_cache"],
        "A_v_cache": _A_in["v_cache"],
        "A_wq": _A_in["wq"],
        "A_wo": _A_in["wo"],
        "B_x": _B_in["x"],
        "B_w1": _B_in["w1"],
        "B_b1": _B_in["b1"],
        "B_w2": _B_in["w2"],
        "B_b2": _B_in["b2"],
        "gate_w": _w((lambda *s: torch.randn(*s, dtype=torch.bfloat16) * 0.05)(576) * 16.0),
    }

def reference(A_x, A_k_cache, A_v_cache, A_wq, A_wo, B_x, B_w1, B_b1, B_w2, B_b2, gate_w):
    def _A_ref(x, k_cache, v_cache, wq, wo):
        B, Sq, D = x.shape
        Hq, Dh = 32, 128
        Hkv, Sk = k_cache.shape[1], k_cache.shape[2]
        W = min(4096, max(256, Sk // 4))
        rep = Hq // Hkv
        q = (lambda x, *d: x.permute(*d))((x @ wq).reshape(B, Sq, Hq, Dh), 0, 2, 1, 3)
        k = (lambda x, n, axis: torch.repeat_interleave(x, n, dim=axis))(k_cache[:, :, Sk - W:, :], rep, axis=1)
        v = (lambda x, n, axis: torch.repeat_interleave(x, n, dim=axis))(v_cache[:, :, Sk - W:, :], rep, axis=1)
        scores = torch.einsum("bhqd,bhkd->bhqk", q, k) * (Dh ** -0.5)
        p = _softmax(scores, axis=-1)
        o = torch.einsum("bhqk,bhkd->bhqd", p, v)
        return (lambda x, *d: x.permute(*d))(o, 0, 2, 1, 3).reshape(B, Sq, Hq * Dh) @ wo

    def _B_ref(x, w1, b1, w2, b2):
        y = _layernorm(x, axis=-1)
        h = _gelu(torch.einsum("bsd,df->bsf", y, w1) + b1)
        return torch.einsum("bsf,fd->bsd", h, w2) + b2

    x = A_x
    g = _sigmoid((x * gate_w).sum(-1, keepdims=True))
    a = _A_ref(x, A_k_cache, A_v_cache, A_wq, A_wo)
    b = _B_ref(x, B_w1, B_b1, B_w2, B_b2)
    return g * a + (1 - g) * b
```

```asm
; @launch grid=(256,1,1) block=(576,1,1) lds=23680
.amdgcn_target "amdgcn-amd-amdhsa--gfx950"
.text
.globl gated_mix__sliding_block_cached__mixer_channel_mlp__decode_kernel
.p2align 8
.type gated_mix__sliding_block_cached__mixer_channel_mlp__decode_kernel,@function
gated_mix__sliding_block_cached__mixer_channel_mlp__decode_kernel:
    s_cmp_ge_u32 s2, 256
    s_cbranch_scc1 L_end
    s_load_dwordx16 s[16:31], s[0:1], 0
    s_load_dwordx8 s[32:39], s[0:1], 64
    s_load_dwordx4 s[40:43], s[0:1], 96
    v_lshrrev_b32 v1, 6, v0
    v_and_b32 v0, 63, v0
    v_readfirstlane_b32 s3, v1
    s_and_b32 s8, s2, 7
    s_bfe_u32 s9, s2, 0x10003
    s_lshl_b32 s4, s8, 1
    s_add_u32 s4, s4, s9
    s_lshr_b32 s5, s2, 4
    s_lshr_b32 s6, s5, 2
    s_and_b32 s7, s5, 3
    s_mov_b32 s54, 0x480000
    s_mov_b32 s55, 0x20000
    s_mov_b32 s74, 0x480
    s_mov_b32 s75, 0x20000
    v_lshrrev_b32 v21, 3, v0
    v_and_b32 v1, 7, v0
    v_lshlrev_b32 v2, 4, v1
    v_lshl_add_u32 v14, v21, 14, v2
    v_lshlrev_b32 v3, 2, v21
    s_mul_i32 s92, s6, 288
    s_lshl_b32 s8, s3, 5
    s_add_u32 s92, s92, s8
    s_lshl_b32 s93, s92, 12
    s_lshl_b32 s8, s4, 9
    s_add_u32 s93, s93, s8
    s_lshl_b32 s8, s7, 7
    s_add_u32 s93, s93, s8
    s_add_u32 s94, s93, 8192
    s_waitcnt lgkmcnt(0)
    s_mov_b32 s52, s22
    s_mov_b32 s53, s23
    s_mov_b32 s72, s16
    s_mov_b32 s73, s17
    buffer_load_dword v148, v3, s[72:75], s92 offen
    buffer_load_dwordx4 v[32:35], v14, s[52:55], s93 offen nt
    buffer_load_dwordx4 v[36:39], v14, s[52:55], s94 offen nt
    s_mov_b32 s46, 0x8000000
    s_mov_b32 s47, 0x20000
    s_mov_b32 s50, 0x8000000
    s_mov_b32 s51, 0x20000
    s_mov_b32 s58, 0x480000
    s_mov_b32 s59, 0x20000
    s_mov_b32 s62, 0x510000
    s_mov_b32 s63, 0x20000
    s_mov_b32 s66, 0x510000
    s_mov_b32 s67, 0x20000
    s_mov_b32 s70, 0x20000000
    s_mov_b32 s71, 0x20000
    s_mov_b32 s78, 0x480
    s_mov_b32 s79, 0x20000
    s_mov_b32 s82, 0x2400
    s_mov_b32 s83, 0x20000
    s_mov_b32 s86, 0x480
    s_mov_b32 s87, 0x20000
    s_mov_b32 s90, 0x480
    s_mov_b32 s91, 0x20000
    s_mov_b32 s68, s42
    s_mov_b32 s69, s43
    s_mul_i32 s95, s2, 911
    s_lshr_b32 s95, s95, 16
    s_mul_i32 s8, s95, 72
    s_sub_u32 s15, s2, s8
    s_cmp_lt_u32 s95, 3
    s_cselect_b32 s14, s95, 0
    s_cselect_b32 s10, 0, 1
    s_lshl_b32 s10, s10, 31
    v_mov_b32 v23, 0
    v_mul_u32_u24 v4, 9216, v21
    v_add_u32 v15, v4, v2
    v_or_b32 v15, s10, v15
    s_cmp_eq_u32 s3, 8
    s_cbranch_scc1 L_role1
    s_mov_b32 s60, s28
    s_mov_b32 s61, s29
    s_mov_b32 s44, s18
    s_mov_b32 s45, s19
    s_mov_b32 s48, s20
    s_mov_b32 s49, s21
    s_mov_b32 s56, s24
    s_mov_b32 s57, s25
    s_mul_i32 s16, s14, 192
    s_mul_i32 s8, s3, 24
    s_add_u32 s16, s16, s8
    s_lshl_b32 s29, s16, 1
    s_mul_i32 s16, s16, 9216
    s_lshl_b32 s8, s15, 7
    s_add_u32 s16, s16, s8
    s_add_u32 s17, s16, 73728
    s_add_u32 s18, s17, 73728
    v_lshlrev_b32 v4, 1, v21
    buffer_load_ushort v150, v4, s[72:75], s29 offen offset:0
    buffer_load_ushort v151, v4, s[72:75], s29 offen offset:16
    buffer_load_ushort v152, v4, s[72:75], s29 offen offset:32
    s_lshl_b32 s19, s4, 23
    s_add_u32 s19, s19, 7340032
    s_lshl_b32 s8, s5, 16
    s_add_u32 s19, s19, s8
    s_mul_i32 s8, s5, 3
    s_add_u32 s8, s8, s3
    s_and_b32 s8, s8, 7
    s_lshl_b32 s8, s8, 10
    s_add_u32 s19, s19, s8
    s_mov_b32 s22, s3
    buffer_load_dwordx4 v[40:43], v15, s[60:63], s16 offen nt
    buffer_load_dwordx4 v[44:47], v15, s[60:63], s17 offen nt
    v_and_b32 v1, 7, v0
    v_lshlrev_b32 v2, 4, v1
    v_mul_u32_u24 v4, 1152, v21
    v_add_u32 v16, v4, v2
    v_add_u32 v164, v4, v16
    v_mov_b32 v5, 0x80000000
    v_cmp_gt_u32 vcc, 16, v0
    s_nop 1
    v_cndmask_b32 v17, v5, v16, vcc
    v_bfe_u32 v4, v0, 2, 2
    v_lshlrev_b32 v4, 8, v4
    v_lshrrev_b32 v6, 4, v0
    v_lshl_add_u32 v4, v6, 6, v4
    v_and_b32 v7, 3, v0
    v_lshl_add_u32 v18, v7, 4, v4
    v_lshlrev_b32 v19, 4, v0
    v_and_b32 v4, 1, v0
    v_lshlrev_b32 v4, 4, v4
    v_mov_b32 v7, 0xffff
    v_lshlrev_b32 v4, v4, v7
    v_lshrrev_b32 v7, 1, v1
    v_cmp_eq_u32 vcc, 0, v7
    s_nop 1
    v_cndmask_b32 v10, 0, v4, vcc
    v_cmp_eq_u32 vcc, 1, v7
    s_nop 1
    v_cndmask_b32 v11, 0, v4, vcc
    v_cmp_eq_u32 vcc, 2, v7
    s_nop 1
    v_cndmask_b32 v12, 0, v4, vcc
    v_cmp_eq_u32 vcc, 3, v7
    s_nop 1
    v_cndmask_b32 v13, 0, v4, vcc
    v_lshrrev_b32 v4, 5, v0
    v_lshlrev_b32 v4, 8, v4
    v_lshl_add_u32 v4, v1, 5, v4
    v_and_b32 v7, 1, v6
    v_lshl_add_u32 v4, v7, 4, v4
    s_lshl_b32 s8, s3, 9
    v_add_u32 v20, s8, v4
    s_mov_b32 s64, s32
    s_mov_b32 s65, s33
    s_mov_b32 s84, s34
    s_mov_b32 s85, s35
    s_mov_b32 s88, s38
    s_mov_b32 s89, s39
    s_mul_i32 s24, s2, 20736
    s_lshl_b32 s8, s3, 7
    s_add_u32 s24, s24, s8
    s_add_u32 s25, s24, 9216
    s_add_u32 s26, s25, 9216
    s_lshl_b32 s27, s4, 8
    s_lshl_b32 s9, s5, 4
    s_add_u32 s27, s27, s9
    s_mul_i32 s27, s27, 1152
    s_add_u32 s27, s27, s8
    s_add_u32 s28, s27, 1152
    s_waitcnt lgkmcnt(0)
    s_barrier
    s_waitcnt vmcnt(7)
    s_mov_b32 s12, 0x01000100
    s_mov_b32 s13, 0x03020302
    v_perm_b32 v1, v148, v148, s12
    v_perm_b32 v2, v148, v148, s13
    v_and_b32 v116, v1, v10
    v_and_b32 v117, v1, v11
    v_and_b32 v118, v1, v12
    v_and_b32 v119, v1, v13
    v_and_b32 v120, v2, v10
    v_and_b32 v121, v2, v11
    v_and_b32 v122, v2, v12
    v_and_b32 v123, v2, v13
    s_waitcnt vmcnt(6)
    v_mfma_f32_16x16x32_bf16 v[24:27], v[116:119], v[32:35], 0
    s_waitcnt vmcnt(5)
    buffer_load_dwordx4 v[48:51], v15, s[60:63], s18 offen nt
    v_mfma_f32_16x16x32_bf16 v[24:27], v[120:123], v[36:39], v[24:27]
    s_waitcnt vmcnt(3)
    v_lshl_or_b32 v150, v150, 16, v150
    v_and_b32 v124, v150, v10
    v_and_b32 v125, v150, v11
    v_and_b32 v126, v150, v12
    v_and_b32 v127, v150, v13
    v_lshl_or_b32 v151, v151, 16, v151
    v_and_b32 v128, v151, v10
    v_and_b32 v129, v151, v11
    v_and_b32 v130, v151, v12
    v_and_b32 v131, v151, v13
    v_lshl_or_b32 v152, v152, 16, v152
    v_and_b32 v132, v152, v10
    v_and_b32 v133, v152, v11
    v_and_b32 v134, v152, v12
    v_and_b32 v135, v152, v13
    v_mov_b32 v1, 0x3f803f80
    v_and_b32 v136, v1, v10
    v_and_b32 v137, v1, v11
    v_and_b32 v138, v1, v12
    v_and_b32 v139, v1, v13
    s_mov_b32 exec_lo, 0xff00ff
    s_mov_b32 exec_hi, 0xff00ff00
    ds_write_b128 v20, v[24:27] offset:0
    s_mov_b64 exec, -1
    s_lshl_b32 s8, s3, 2
    v_mov_b32 v8, s8
    v_mov_b32 v9, 1
    s_mov_b32 exec_lo, 0x1
    s_mov_b32 exec_hi, 0x0
    ds_write_b32 v8, v9 offset:14208
    s_mov_b64 exec, -1
    s_waitcnt vmcnt(2)
    s_add_u32 s11, s22, 0
    s_and_b32 s11, s11, 7
    s_lshl_b32 s11, s11, 13
    s_add_u32 s11, s11, s19
    buffer_load_dwordx4 v[52:55], v18, s[44:47], s11 offen nt
    v_mfma_f32_16x16x32_bf16 v[28:31], v[124:127], v[40:43], 0
    v_mfma_f32_16x16x32_bf16 v[160:163], v[136:139], v[40:43], 0
    s_waitcnt vmcnt(2)
    s_add_u32 s11, s22, 1
    s_and_b32 s11, s11, 7
    s_lshl_b32 s11, s11, 13
    s_add_u32 s11, s11, s19
    buffer_load_dwordx4 v[56:59], v18, s[44:47], s11 offen nt
    v_mfma_f32_16x16x32_bf16 v[28:31], v[128:131], v[44:47], v[28:31]
    v_mfma_f32_16x16x32_bf16 v[160:163], v[136:139], v[44:47], v[160:163]
    s_waitcnt vmcnt(2)
    s_add_u32 s11, s22, 2
    s_and_b32 s11, s11, 7
    s_lshl_b32 s11, s11, 13
    s_add_u32 s11, s11, s19
    buffer_load_dwordx4 v[60:63], v18, s[44:47], s11 offen nt
    v_mfma_f32_16x16x32_bf16 v[28:31], v[132:135], v[48:51], v[28:31]
    v_mfma_f32_16x16x32_bf16 v[160:163], v[136:139], v[48:51], v[160:163]
    s_mov_b32 exec_lo, 0xff00ff
    s_mov_b32 exec_hi, 0xff00ff00
    s_nop 4
    ds_write_b128 v20, v[28:31] offset:4608
    ds_write_b128 v20, v[160:163] offset:8704
    s_mov_b64 exec, -1
    s_lshl_b32 s8, s3, 2
    v_mov_b32 v8, s8
    v_mov_b32 v9, 1
    s_mov_b32 exec_lo, 0x1
    s_mov_b32 exec_hi, 0x0
    ds_write_b32 v8, v9 offset:14240
    s_mov_b64 exec, -1
    s_waitcnt vmcnt(2)
    s_add_u32 s11, s22, 3
    s_and_b32 s11, s11, 7
    s_lshl_b32 s11, s11, 13
    s_add_u32 s11, s11, s19
    buffer_load_dwordx4 v[64:67], v18, s[44:47], s11 offen nt
    v_bfe_u32 v3, v0, 3, 1
    v_lshlrev_b32 v1, 8, v3
    v_lshrrev_b32 v2, 4, v0
    v_lshl_add_u32 v1, v2, 6, v1
    v_and_b32 v2, 3, v0
    v_lshl_add_u32 v14, v2, 4, v1
    v_lshlrev_b32 v155, 5, v3
    s_lshl_b32 s8, s3, 2
    v_add_u32 v156, s8, v155
    s_waitcnt vmcnt(2)
    s_add_u32 s11, s22, 4
    s_and_b32 s11, s11, 7
    s_lshl_b32 s11, s11, 13
    s_add_u32 s11, s11, s19
    buffer_load_dwordx4 v[68:71], v18, s[44:47], s11 offen nt
    v_and_b32 v1, 7, v0
    v_lshlrev_b32 v1, 5, v1
    v_bfe_u32 v2, v0, 4, 1
    v_lshl_add_u32 v1, v2, 4, v1
    v_lshrrev_b32 v2, 5, v0
    v_lshl_add_u32 v157, v2, 3, v1
    s_mul_i32 s34, s2, 2432
    s_lshl_b32 s9, s3, 8
    s_add_u32 s34, s34, s9
    s_add_u32 s34, s34, 0x200000
    s_waitcnt vmcnt(2)
    s_add_u32 s11, s22, 5
    s_and_b32 s11, s11, 7
    s_lshl_b32 s11, s11, 13
    s_add_u32 s11, s11, s19
    buffer_load_dwordx4 v[72:75], v18, s[44:47], s11 offen nt
    v_lshrrev_b32 v1, 5, v0
    v_lshlrev_b32 v1, 9, v1
    v_and_b32 v2, 15, v0
    v_lshl_add_u32 v1, v2, 5, v1
    v_bfe_u32 v2, v0, 4, 1
    v_lshl_add_u32 v1, v2, 4, v1
    s_lshl_b32 s8, s3, 10
    v_add_u32 v152, s8, v1
    v_lshlrev_b32 v20, 3, v21
    s_waitcnt vmcnt(2)
    s_add_u32 s11, s22, 6
    s_and_b32 s11, s11, 7
    s_lshl_b32 s11, s11, 13
    s_add_u32 s11, s11, s19
    buffer_load_dwordx4 v[76:79], v18, s[44:47], s11 offen nt
    v_lshrrev_b32 v2, 5, v0
    v_lshlrev_b32 v2, 12, v2
    v_and_b32 v3, 31, v0
    v_lshl_add_u32 v2, v3, 2, v2
    s_lshl_b32 s8, s3, 7
    v_lshl_add_u32 v15, v3, 2, s8
    s_add_u32 s8, s8, 14464
    v_add_u32 v153, s8, v2
    v_lshlrev_b32 v154, 2, v3
    s_waitcnt vmcnt(2)
    s_add_u32 s11, s22, 7
    s_and_b32 s11, s11, 7
    s_lshl_b32 s11, s11, 13
    s_add_u32 s11, s11, s19
    buffer_load_dwordx4 v[80:83], v18, s[44:47], s11 offen nt
    v_mov_b32 v8, 0
    v_mov_b32 v9, 1
    s_mov_b32 exec_lo, 0x1
    s_mov_b32 exec_hi, 0x0
    ds_write_b32 v8, v9 offset:14344
    s_mov_b64 exec, -1
    s_lshl_b32 s35, s4, 4
    s_add_u32 s35, s35, s5
    s_lshl_b32 s35, s35, 10
    s_lshl_b32 s9, s3, 7
    s_add_u32 s35, s35, s9
    s_add_u32 s36, s35, 0x80000
    s_add_u32 s35, s35, 0x180000
    v_mul_u32_u24 v4, 2432, v21
    v_and_b32 v5, 7, v0
    v_lshl_add_u32 v165, v5, 4, v4
    s_sub_u32 s23, s2, 238
    s_max_i32 s23, s23, 0
    s_waitcnt vmcnt(2)
    s_add_u32 s11, s22, 0
    s_and_b32 s11, s11, 7
    s_lshl_b32 s11, s11, 13
    s_add_u32 s11, s11, s19
    buffer_load_dwordx4 v[84:87], v19, s[48:51], s11 offen nt
    s_mul_i32 s21, s3, 77824
    s_lshl_b32 s8, s23, 7
    s_add_u32 s21, s21, s8
    s_add_u32 s21, s21, 0x200000
    s_add_u32 s17, s21, 19456
    s_add_u32 s18, s21, 38912
    s_add_u32 s20, s21, 58368
    v_and_b32 v5, 7, v0
    v_lshlrev_b32 v166, 4, v5
    v_bfe_u32 v4, v0, 4, 1
    v_lshl_add_u32 v166, v4, 3, v166
    v_lshrrev_b32 v4, 5, v0
    v_lshl_add_u32 v166, v4, 2, v166
    s_lshl_b32 s8, s3, 7
    v_add_u32 v166, s8, v166
    s_waitcnt vmcnt(2)
    s_add_u32 s11, s22, 1
    s_and_b32 s11, s11, 7
    s_lshl_b32 s11, s11, 13
    s_add_u32 s11, s11, s19
    buffer_load_dwordx4 v[88:91], v19, s[48:51], s11 offen nt
    v_lshlrev_b32 v1, 1, v0
    v_cmp_gt_u32 vcc, 32, v0
    v_mov_b32 v4, 0x80000000
    s_nop 0
    v_cndmask_b32 v167, v4, v1, vcc
    s_lshl_b32 s16, s23, 6
    buffer_load_ushort v151, v167, s[84:87], s16 offen
    s_waitcnt vmcnt(3)
    s_add_u32 s11, s22, 2
    s_and_b32 s11, s11, 7
    s_lshl_b32 s11, s11, 13
    s_add_u32 s11, s11, s19
    buffer_load_dwordx4 v[92:95], v19, s[48:51], s11 offen nt
    v_mov_b32 v8, 0
    s_mov_b32 s97, 0x100000
L_aw_1:
    ds_read_b32 v9, v8 offset:14336
    ds_read_b128 v[24:27], v14 offset:12864
    s_waitcnt lgkmcnt(0)
    v_cmp_eq_u32 vcc, 1, v9
    s_cmp_eq_u64 vcc, -1
    s_cbranch_scc1 L_awok_2
    s_sub_u32 s97, s97, 1
    s_cmp_eq_u32 s97, 0
    s_cbranch_scc0 L_aw_1
L_awok_2:
    v_mfma_f32_16x16x32_bf16 v[116:119], v[52:55], v[24:27], 0
    v_mfma_f32_16x16x32_bf16 v[120:123], v[56:59], v[24:27], 0
    v_mfma_f32_16x16x32_bf16 v[124:127], v[60:63], v[24:27], 0
    v_mfma_f32_16x16x32_bf16 v[128:131], v[64:67], v[24:27], 0
    v_mfma_f32_16x16x32_bf16 v[132:135], v[68:71], v[24:27], 0
    v_mfma_f32_16x16x32_bf16 v[136:139], v[72:75], v[24:27], 0
    v_mfma_f32_16x16x32_bf16 v[140:143], v[76:79], v[24:27], 0
    v_mfma_f32_16x16x32_bf16 v[144:147], v[80:83], v[24:27], 0
    s_nop 7
    v_mov_b32_dpp v76, v116 quad_perm:[0,0,0,0] row_mask:0xf bank_mask:0xf
    v_mov_b32_dpp v77, v120 quad_perm:[0,0,0,0] row_mask:0xf bank_mask:0xf
    v_mov_b32_dpp v78, v124 quad_perm:[0,0,0,0] row_mask:0xf bank_mask:0xf
    v_mov_b32_dpp v79, v128 quad_perm:[0,0,0,0] row_mask:0xf bank_mask:0xf
    v_mov_b32_dpp v80, v132 quad_perm:[0,0,0,0] row_mask:0xf bank_mask:0xf
    v_mov_b32_dpp v81, v136 quad_perm:[0,0,0,0] row_mask:0xf bank_mask:0xf
    v_mov_b32_dpp v82, v140 quad_perm:[0,0,0,0] row_mask:0xf bank_mask:0xf
    v_mov_b32_dpp v83, v144 quad_perm:[0,0,0,0] row_mask:0xf bank_mask:0xf
    v_add_f32_dpp v76, v117, v76 quad_perm:[1,1,1,1] row_mask:0xf bank_mask:0xf
    v_add_f32_dpp v77, v121, v77 quad_perm:[1,1,1,1] row_mask:0xf bank_mask:0xf
    v_add_f32_dpp v78, v125, v78 quad_perm:[1,1,1,1] row_mask:0xf bank_mask:0xf
    v_add_f32_dpp v79, v129, v79 quad_perm:[1,1,1,1] row_mask:0xf bank_mask:0xf
    v_add_f32_dpp v80, v133, v80 quad_perm:[1,1,1,1] row_mask:0xf bank_mask:0xf
    v_add_f32_dpp v81, v137, v81 quad_perm:[1,1,1,1] row_mask:0xf bank_mask:0xf
    v_add_f32_dpp v82, v141, v82 quad_perm:[1,1,1,1] row_mask:0xf bank_mask:0xf
    v_add_f32_dpp v83, v145, v83 quad_perm:[1,1,1,1] row_mask:0xf bank_mask:0xf
    v_add_f32_dpp v76, v118, v76 quad_perm:[2,2,2,2] row_mask:0xf bank_mask:0xf
    v_add_f32_dpp v77, v122, v77 quad_perm:[2,2,2,2] row_mask:0xf bank_mask:0xf
    v_add_f32_dpp v78, v126, v78 quad_perm:[2,2,2,2] row_mask:0xf bank_mask:0xf
    v_add_f32_dpp v79, v130, v79 quad_perm:[2,2,2,2] row_mask:0xf bank_mask:0xf
    v_add_f32_dpp v80, v134, v80 quad_perm:[2,2,2,2] row_mask:0xf bank_mask:0xf
    v_add_f32_dpp v81, v138, v81 quad_perm:[2,2,2,2] row_mask:0xf bank_mask:0xf
    v_add_f32_dpp v82, v142, v82 quad_perm:[2,2,2,2] row_mask:0xf bank_mask:0xf
    v_add_f32_dpp v83, v146, v83 quad_perm:[2,2,2,2] row_mask:0xf bank_mask:0xf
    v_add_f32_dpp v76, v119, v76 quad_perm:[3,3,3,3] row_mask:0xf bank_mask:0xf
    v_add_f32_dpp v77, v123, v77 quad_perm:[3,3,3,3] row_mask:0xf bank_mask:0xf
    v_add_f32_dpp v78, v127, v78 quad_perm:[3,3,3,3] row_mask:0xf bank_mask:0xf
    v_add_f32_dpp v79, v131, v79 quad_perm:[3,3,3,3] row_mask:0xf bank_mask:0xf
    v_add_f32_dpp v80, v135, v80 quad_perm:[3,3,3,3] row_mask:0xf bank_mask:0xf
    v_add_f32_dpp v81, v139, v81 quad_perm:[3,3,3,3] row_mask:0xf bank_mask:0xf
    v_add_f32_dpp v82, v143, v82 quad_perm:[3,3,3,3] row_mask:0xf bank_mask:0xf
    v_add_f32_dpp v83, v147, v83 quad_perm:[3,3,3,3] row_mask:0xf bank_mask:0xf
    v_max3_f32 v1, v76, v77, v78
    v_max3_f32 v2, v79, v80, v81
    v_max3_f32 v1, v1, v82, v83
    v_max_f32 v1, v1, v2
    v_mov_b32 v2, v1
    s_nop 1
    v_permlane16_swap_b32 v1, v2
    v_max_f32 v1, v1, v2
    v_mov_b32 v2, v1
    s_nop 1
    v_permlane32_swap_b32 v1, v2
    v_max_f32 v1, v1, v2
    s_mov_b32 exec_lo, 0x101
    s_mov_b32 exec_hi, 0x0
    ds_write_b32 v156, v1 offset:13376
    s_mov_b64 exec, -1
    s_lshl_b32 s8, s3, 2
    v_mov_b32 v8, s8
    v_mov_b32 v9, 1
    s_mov_b32 exec_lo, 0x1
    s_mov_b32 exec_hi, 0x0
    ds_write_b32 v8, v9 offset:14272
    s_mov_b64 exec, -1
    s_waitcnt vmcnt(3)
    s_add_u32 s11, s22, 3
    s_and_b32 s11, s11, 7
    s_lshl_b32 s11, s11, 13
    s_add_u32 s11, s11, s19
    buffer_load_dwordx4 v[96:99], v19, s[48:51], s11 offen nt
    s_waitcnt vmcnt(3)
    s_add_u32 s11, s22, 4
    s_and_b32 s11, s11, 7
    s_lshl_b32 s11, s11, 13
    s_add_u32 s11, s11, s19
    buffer_load_dwordx4 v[100:103], v19, s[48:51], s11 offen nt
    v_and_b32 v8, 7, v0
    v_lshlrev_b32 v8, 2, v8
    s_mov_b32 s97, 0x100000
L_aw_3:
    ds_read_b32 v9, v8 offset:14272
    ds_read_b128 v[24:27], v155 offset:13376
    ds_read_b128 v[28:31], v155 offset:13392
    ds_read_b64 v[2:3], v23 offset:12816
    s_waitcnt lgkmcnt(0)
    v_cmp_eq_u32 vcc, 1, v9
    s_cmp_eq_u64 vcc, -1
    s_cbranch_scc1 L_awok_4
    s_sub_u32 s97, s97, 1
    s_cmp_eq_u32 s97, 0
    s_cbranch_scc0 L_aw_3
L_awok_4:
    v_mov_b32 v22, v2
    v_readfirstlane_b32 s96, v2
    v_readfirstlane_b32 s29, v3
    v_max3_f32 v1, v24, v25, v26
    v_max3_f32 v2, v27, v28, v29
    v_max3_f32 v1, v1, v30, v31
    v_max_f32 v1, v1, v2
    s_mov_b32 s14, 0x3e0293ee
    v_mul_f32 v1, s14, v1
    v_fma_f32 v76, v76, s14, -v1
    v_fma_f32 v77, v77, s14, -v1
    v_fma_f32 v78, v78, s14, -v1
    v_fma_f32 v79, v79, s14, -v1
    v_fma_f32 v80, v80, s14, -v1
    v_fma_f32 v81, v81, s14, -v1
    v_fma_f32 v82, v82, s14, -v1
    v_fma_f32 v83, v83, s14, -v1
    v_exp_f32 v76, v76
    v_exp_f32 v77, v77
    v_exp_f32 v78, v78
    v_exp_f32 v79, v79
    v_exp_f32 v80, v80
    v_exp_f32 v81, v81
    v_exp_f32 v82, v82
    v_exp_f32 v83, v83
    v_add_f32 v2, v76, v77
    v_add_f32 v5, v78, v79
    v_add_f32 v6, v80, v81
    v_add_f32 v7, v82, v83
    v_add_f32 v2, v2, v5
    v_add_f32 v6, v6, v7
    v_add_f32 v2, v2, v6
    v_mov_b32 v5, v2
    s_nop 1
    v_permlane16_swap_b32 v2, v5
    v_add_f32 v2, v2, v5
    v_mov_b32 v5, v2
    s_nop 1
    v_permlane32_swap_b32 v2, v5
    v_add_f32 v2, v2, v5
    s_mov_b32 exec_lo, 0x101
    s_mov_b32 exec_hi, 0x0
    ds_write_b32 v156, v2 offset:13440
    s_mov_b64 exec, -1
    s_lshl_b32 s8, s3, 2
    v_mov_b32 v8, s8
    v_mov_b32 v9, 1
    s_mov_b32 exec_lo, 0x1
    s_mov_b32 exec_hi, 0x0
    ds_write_b32 v8, v9 offset:14304
    s_mov_b64 exec, -1
    v_cvt_pk_bf16_f32 v76, v76, v76
    v_cvt_pk_bf16_f32 v77, v77, v77
    v_cvt_pk_bf16_f32 v78, v78, v78
    v_cvt_pk_bf16_f32 v79, v79, v79
    v_cvt_pk_bf16_f32 v80, v80, v80
    v_cvt_pk_bf16_f32 v81, v81, v81
    v_cvt_pk_bf16_f32 v82, v82, v82
    v_cvt_pk_bf16_f32 v83, v83, v83
    v_and_b32 v116, v76, v10
    v_and_b32 v117, v76, v11
    v_and_b32 v118, v76, v12
    v_and_b32 v119, v76, v13
    v_and_b32 v120, v77, v10
    v_and_b32 v121, v77, v11
    v_and_b32 v122, v77, v12
    v_and_b32 v123, v77, v13
    v_and_b32 v124, v78, v10
    v_and_b32 v125, v78, v11
    v_and_b32 v126, v78, v12
    v_and_b32 v127, v78, v13
    v_and_b32 v128, v79, v10
    v_and_b32 v129, v79, v11
    v_and_b32 v130, v79, v12
    v_and_b32 v131, v79, v13
    v_and_b32 v132, v80, v10
    v_and_b32 v133, v80, v11
    v_and_b32 v134, v80, v12
    v_and_b32 v135, v80, v13
    v_and_b32 v136, v81, v10
    v_and_b32 v137, v81, v11
    v_and_b32 v138, v81, v12
    v_and_b32 v139, v81, v13
    v_and_b32 v140, v82, v10
    v_and_b32 v141, v82, v11
    v_and_b32 v142, v82, v12
    v_and_b32 v143, v82, v13
    v_and_b32 v144, v83, v10
    v_and_b32 v145, v83, v11
    v_and_b32 v146, v83, v12
    v_and_b32 v147, v83, v13
    v_mov_b32 v149, v22
    v_mov_b32 v5, v22
    v_mfma_f32_16x16x32_bf16 v[24:27], v[116:119], v[84:87], 0
    v_mfma_f32_16x16x32_bf16 v[24:27], v[120:123], v[88:91], v[24:27]
    s_waitcnt vmcnt(2)
    s_add_u32 s11, s22, 5
    s_and_b32 s11, s11, 7
    s_lshl_b32 s11, s11, 13
    s_add_u32 s11, s11, s19
    buffer_load_dwordx4 v[104:107], v19, s[48:51], s11 offen nt
    v_mfma_f32_16x16x32_bf16 v[24:27], v[124:127], v[92:95], v[24:27]
    s_waitcnt vmcnt(2)
    s_add_u32 s11, s22, 6
    s_and_b32 s11, s11, 7
    s_lshl_b32 s11, s11, 13
    s_add_u32 s11, s11, s19
    buffer_load_dwordx4 v[108:111], v19, s[48:51], s11 offen nt
    v_mfma_f32_16x16x32_bf16 v[24:27], v[128:131], v[96:99], v[24:27]
    s_waitcnt vmcnt(2)
    s_add_u32 s11, s22, 7
    s_and_b32 s11, s11, 7
    s_lshl_b32 s11, s11, 13
    s_add_u32 s11, s11, s19
    buffer_load_dwordx4 v[112:115], v19, s[48:51], s11 offen nt
    v_mfma_f32_16x16x32_bf16 v[24:27], v[132:135], v[100:103], v[24:27]
    s_waitcnt vmcnt(2)
    buffer_load_dwordx4 v[40:43], v16, s[64:67], s24 offen nt
    v_mfma_f32_16x16x32_bf16 v[24:27], v[136:139], v[104:107], v[24:27]
    s_waitcnt vmcnt(2)
    buffer_load_dwordx4 v[44:47], v16, s[64:67], s25 offen nt
    v_mfma_f32_16x16x32_bf16 v[24:27], v[140:143], v[108:111], v[24:27]
    s_waitcnt vmcnt(2)
    buffer_load_dwordx4 v[48:51], v17, s[64:67], s26 offen nt
    v_mfma_f32_16x16x32_bf16 v[24:27], v[144:147], v[112:115], v[24:27]
    buffer_load_dwordx4 v[32:35], v164, s[56:59], s27 offen nt
    buffer_load_dwordx4 v[36:39], v164, s[56:59], s28 offen nt
    s_nop 5
    ds_write_b128 v152, v[24:27] offset:14464
    s_lshl_b32 s8, s3, 2
    v_mov_b32 v8, s8
    v_mov_b32 v9, 1
    s_mov_b32 exec_lo, 0x1
    s_mov_b32 exec_hi, 0x0
    ds_write_b32 v8, v9 offset:14368
    s_mov_b64 exec, -1
    v_and_b32 v8, 7, v0
    v_lshlrev_b32 v8, 2, v8
    s_mov_b32 s97, 0x100000
L_aw_5:
    ds_read_b32 v9, v8 offset:14368
    ds_read2st64_b32 v[2:3], v153 offset0:0 offset1:4
    ds_read2st64_b32 v[6:7], v153 offset0:8 offset1:12
    s_waitcnt lgkmcnt(0)
    v_cmp_eq_u32 vcc, 1, v9
    s_cmp_eq_u64 vcc, -1
    s_cbranch_scc1 L_awok_6
    s_sub_u32 s97, s97, 1
    s_cmp_eq_u32 s97, 0
    s_cbranch_scc0 L_aw_5
L_awok_6:
    v_add_f32 v2, v2, v3
    v_add_f32 v6, v6, v7
    v_add_f32 v4, v2, v6
    v_mov_b32 v2, v4
    s_nop 1
    v_permlane32_swap_b32 v4, v2
    v_add_f32 v6, v4, v2
    s_nop 1
    v_mov_b32_dpp v7, v6 quad_perm:[1,0,3,2] row_mask:0xf bank_mask:0xf
    v_cvt_pk_bf16_f32 v4, v6, v7
    s_mov_b32 exec_lo, 0x55555555
    s_mov_b32 exec_hi, 0x0
    buffer_store_dwordx2 v[4:5], v154, s[68:71], s35 offen
    s_mov_b32 exec_lo, 0xffffffff
    s_mov_b32 exec_hi, 0x0
    ds_write_b32 v15, v6 offset:22656
    s_mov_b64 exec, -1
    s_lshl_b32 s8, s3, 2
    v_mov_b32 v8, s8
    v_mov_b32 v9, 1
    s_mov_b32 exec_lo, 0x1
    s_mov_b32 exec_hi, 0x0
    ds_write_b32 v8, v9 offset:14400
    s_mov_b64 exec, -1
    v_add_u32 v150, 1, v22
    v_mov_b32 v7, v150
    v_mov_b32 v6, v7
    s_mov_b32 exec_lo, 0xff00ff
    s_mov_b32 exec_hi, 0xff00ff00
    buffer_store_dwordx2 v[6:7], v157, s[68:71], s34 offen sc1
    s_mov_b64 exec, -1
    v_lshlrev_b32 v6, 2, v21
    v_mov_b32 v8, 0
    s_mov_b32 s97, 0x100000
L_aw_7:
    ds_read_b32 v9, v8 offset:14340
    ds_read_b32 v1, v6 offset:13504
    ds_read_b32 v2, v6 offset:13536
    ds_read_b32 v3, v6 offset:13568
    s_waitcnt lgkmcnt(0)
    v_cmp_eq_u32 vcc, 1, v9
    s_cmp_eq_u64 vcc, -1
    s_cbranch_scc1 L_awok_8
    s_sub_u32 s97, s97, 1
    s_cmp_eq_u32 s97, 0
    s_cbranch_scc0 L_aw_7
L_awok_8:
    v_and_b32 v52, v1, v10
    v_and_b32 v53, v1, v11
    v_and_b32 v54, v1, v12
    v_and_b32 v55, v1, v13
    v_and_b32 v56, v2, v10
    v_and_b32 v57, v2, v11
    v_and_b32 v58, v2, v12
    v_and_b32 v59, v2, v13
    v_and_b32 v60, v3, v10
    v_and_b32 v61, v3, v11
    v_and_b32 v62, v3, v12
    v_and_b32 v63, v3, v13
    s_waitcnt vmcnt(6)
    v_mfma_f32_16x16x32_bf16 v[160:163], v[52:55], v[40:43], 0
    s_waitcnt vmcnt(5)
    v_mfma_f32_16x16x32_bf16 v[160:163], v[56:59], v[44:47], v[160:163]
    s_waitcnt vmcnt(4)
    v_mfma_f32_16x16x32_bf16 v[160:163], v[60:63], v[48:51], v[160:163]
    s_waitcnt vmcnt(3)
    s_waitcnt vmcnt(2)
    s_cmp_eq_u32 s29, 0
    s_cbranch_scc1 L_olocal
    s_mov_b32 exec_lo, 0x55555555
    s_mov_b32 exec_hi, 0x0
    buffer_store_dwordx2 v[4:5], v154, s[68:71], s36 offen sc1
    s_mov_b64 exec, -1
L_olocal:
    s_waitcnt lgkmcnt(0)
    s_barrier
    ds_read_b64 v[6:7], v20 offset:13632
    s_waitcnt lgkmcnt(0)
    v_and_b32 v64, v6, v10
    v_and_b32 v65, v6, v11
    v_and_b32 v66, v6, v12
    v_and_b32 v67, v6, v13
    v_and_b32 v68, v7, v10
    v_and_b32 v69, v7, v11
    v_and_b32 v70, v7, v12
    v_and_b32 v71, v7, v13
    v_mfma_f32_16x16x32_bf16 v[160:163], v[64:67], v[32:35], v[160:163]
    s_nop 0
    v_mfma_f32_16x16x32_bf16 v[160:163], v[68:71], v[36:39], v[160:163]
    s_nop 7
    v_permlane32_swap_b32 v160, v162
    v_permlane32_swap_b32 v161, v163
    s_nop 0
    v_add_f32_dpp v148, v162, v160 row_ror:8 row_mask:0x3 bank_mask:0xf
    v_add_f32_dpp v150, v163, v161 row_ror:8 row_mask:0x3 bank_mask:0xf
    s_nop 0
    v_add_f32_dpp v148, v160, v162 row_ror:8 row_mask:0xc bank_mask:0xf
    v_add_f32_dpp v150, v161, v163 row_ror:8 row_mask:0xc bank_mask:0xf
    s_mov_b32 exec_lo, 0xff00ff
    s_mov_b32 exec_hi, 0xff00ff00
    v_cvt_pk_bf16_f32 v148, v148, v150
    buffer_store_dwordx2 v[148:149], v157, s[68:71], s34 offen sc1
    s_mov_b64 exec, -1
    s_cmp_lt_u32 s2, 238
    s_cbranch_scc1 L_done
    ds_read_b32 v157, v23 offset:12812
    buffer_load_dwordx4 v[116:119], v165, s[68:71], s21 offen sc1
    buffer_load_dwordx4 v[120:123], v165, s[68:71], s17 offen sc1
    buffer_load_dwordx4 v[124:127], v165, s[68:71], s18 offen sc1
    buffer_load_dwordx4 v[128:131], v165, s[68:71], s20 offen sc1
    s_mov_b32 s97, 0x40000
L_mp_9:
    s_waitcnt vmcnt(0)
    s_mov_b32 s37, 0
    v_cmp_ne_u32 vcc, s96, v117
    v_cmp_ne_u32 s[12:13], s96, v119
    s_or_b64 vcc, vcc, s[12:13]
    s_cbranch_scc0 L_mps_11
    s_mov_b64 exec, vcc
    buffer_load_dwordx4 v[116:119], v165, s[68:71], s21 offen sc1
    s_mov_b64 exec, -1
    s_mov_b32 s37, 1
L_mps_11:
    v_cmp_ne_u32 vcc, s96, v121
    v_cmp_ne_u32 s[12:13], s96, v123
    s_or_b64 vcc, vcc, s[12:13]
    s_cbranch_scc0 L_mps_12
    s_mov_b64 exec, vcc
    buffer_load_dwordx4 v[120:123], v165, s[68:71], s17 offen sc1
    s_mov_b64 exec, -1
    s_mov_b32 s37, 1
L_mps_12:
    v_cmp_ne_u32 vcc, s96, v125
    v_cmp_ne_u32 s[12:13], s96, v127
    s_or_b64 vcc, vcc, s[12:13]
    s_cbranch_scc0 L_mps_13
    s_mov_b64 exec, vcc
    buffer_load_dwordx4 v[124:127], v165, s[68:71], s18 offen sc1
    s_mov_b64 exec, -1
    s_mov_b32 s37, 1
L_mps_13:
    v_cmp_ne_u32 vcc, s96, v129
    v_cmp_ne_u32 s[12:13], s96, v131
    s_or_b64 vcc, vcc, s[12:13]
    s_cbranch_scc0 L_mps_14
    s_mov_b64 exec, vcc
    buffer_load_dwordx4 v[128:131], v165, s[68:71], s20 offen sc1
    s_mov_b64 exec, -1
    s_mov_b32 s37, 1
L_mps_14:
    s_cmp_eq_u32 s37, 0
    s_cbranch_scc1 L_mpok_10
    s_sub_u32 s97, s97, 1
    s_cmp_eq_u32 s97, 0
    s_cbranch_scc0 L_mp_9
    s_waitcnt vmcnt(0)
L_mpok_10:
    v_lshlrev_b32 v52, 16, v116
    v_and_b32 v53, 0xffff0000, v116
    v_lshlrev_b32 v54, 16, v118
    v_and_b32 v55, 0xffff0000, v118
    v_lshlrev_b32 v60, 16, v120
    v_and_b32 v61, 0xffff0000, v120
    v_lshlrev_b32 v62, 16, v122
    v_and_b32 v63, 0xffff0000, v122
    v_add_f32 v52, v52, v60
    v_add_f32 v53, v53, v61
    v_add_f32 v54, v54, v62
    v_add_f32 v55, v55, v63
    v_lshlrev_b32 v56, 16, v124
    v_and_b32 v57, 0xffff0000, v124
    v_lshlrev_b32 v58, 16, v126
    v_and_b32 v59, 0xffff0000, v126
    v_add_f32 v52, v52, v56
    v_add_f32 v53, v53, v57
    v_add_f32 v54, v54, v58
    v_add_f32 v55, v55, v59
    v_lshlrev_b32 v60, 16, v128
    v_and_b32 v61, 0xffff0000, v128
    v_lshlrev_b32 v62, 16, v130
    v_and_b32 v63, 0xffff0000, v130
    v_add_f32 v52, v52, v60
    v_add_f32 v53, v53, v61
    v_add_f32 v54, v54, v62
    v_add_f32 v55, v55, v63
    v_permlane32_swap_b32 v52, v53
    s_nop 0
    v_permlane32_swap_b32 v54, v55
    v_add_f32 v52, v52, v53
    v_add_f32 v54, v54, v55
    s_nop 1
    v_permlane16_swap_b32 v52, v54
    v_add_f32 v52, v52, v54
    s_nop 1
    v_add_f32_dpp v52, v52, v52 row_ror:8 row_mask:0xf bank_mask:0xf
    s_mov_b32 exec_lo, 0xff00ff
    s_mov_b32 exec_hi, 0xff00ff
    ds_write_b32 v166, v52 offset:0
    s_mov_b64 exec, -1
    s_waitcnt lgkmcnt(0)
    s_barrier
    s_cmp_eq_u32 s3, 0
    s_cbranch_scc0 L_done
    v_and_b32 v2, 31, v0
    v_lshlrev_b32 v2, 2, v2
    ds_read_b32 v52, v2 offset:0
    ds_read_b32 v53, v2 offset:128
    ds_read_b32 v54, v2 offset:256
    ds_read_b32 v55, v2 offset:384
    ds_read_b32 v56, v2 offset:512
    ds_read_b32 v57, v2 offset:640
    ds_read_b32 v58, v2 offset:768
    ds_read_b32 v59, v2 offset:896
    v_lshlrev_b32 v151, 16, v151
    s_waitcnt lgkmcnt(0)
    v_add_f32 v52, v52, v53
    v_add_f32 v54, v54, v55
    v_add_f32 v56, v56, v57
    v_add_f32 v58, v58, v59
    v_add_f32 v52, v52, v54
    v_add_f32 v56, v56, v58
    v_add_f32 v52, v52, v56
    v_fmac_f32 v52, v151, v157
    v_cvt_pk_bf16_f32 v52, v52, v52
    buffer_store_short v52, v167, s[88:91], s16 offen
    s_cmp_eq_u32 s23, 0
    s_cbranch_scc0 L_done
    s_mov_b32 exec_lo, 0x1
    s_mov_b32 exec_hi, 0x0
    buffer_store_dword v22, v23, s[68:71], 0 offen sc1
    s_mov_b64 exec, -1
    s_branch L_done
L_role1:
    v_lshlrev_b32 v4, 2, v0
    ds_write_b32 v4, v23 offset:14208
    v_lshlrev_b32 v19, 4, v0
    buffer_load_dword v149, v23, s[68:71], 0 offen sc1
    s_mov_b32 s76, s36
    s_mov_b32 s77, s37
    buffer_load_dwordx4 v[52:55], v19, s[72:75], 0 offen
    buffer_load_dwordx4 v[56:59], v19, s[72:75], 0 offen offset:1024
    buffer_load_dwordx4 v[60:63], v19, s[76:79], 0 offen
    buffer_load_dwordx4 v[64:67], v19, s[76:79], 0 offen offset:1024
    v_and_b32 v1, 7, v0
    v_lshlrev_b32 v2, 4, v1
    v_mul_u32_u24 v4, 1152, v21
    v_add_u32 v16, v4, v2
    v_add_u32 v164, v4, v16
    v_mov_b32 v5, 0x80000000
    v_cmp_gt_u32 vcc, 16, v0
    s_nop 1
    v_cndmask_b32 v17, v5, v16, vcc
    v_bfe_u32 v4, v0, 2, 2
    v_lshlrev_b32 v4, 8, v4
    v_lshrrev_b32 v6, 4, v0
    v_lshl_add_u32 v4, v6, 6, v4
    v_and_b32 v7, 3, v0
    v_lshl_add_u32 v18, v7, 4, v4
    v_lshlrev_b32 v19, 4, v0
    v_and_b32 v4, 1, v0
    v_lshlrev_b32 v4, 4, v4
    v_mov_b32 v7, 0xffff
    v_lshlrev_b32 v4, v4, v7
    v_lshrrev_b32 v7, 1, v1
    v_cmp_eq_u32 vcc, 0, v7
    s_nop 1
    v_cndmask_b32 v10, 0, v4, vcc
    v_cmp_eq_u32 vcc, 1, v7
    s_nop 1
    v_cndmask_b32 v11, 0, v4, vcc
    v_cmp_eq_u32 vcc, 2, v7
    s_nop 1
    v_cndmask_b32 v12, 0, v4, vcc
    v_cmp_eq_u32 vcc, 3, v7
    s_nop 1
    v_cndmask_b32 v13, 0, v4, vcc
    v_lshrrev_b32 v4, 5, v0
    v_lshlrev_b32 v4, 8, v4
    v_lshl_add_u32 v4, v1, 5, v4
    v_and_b32 v7, 1, v6
    v_lshl_add_u32 v4, v7, 4, v4
    s_lshl_b32 s8, s3, 9
    v_add_u32 v20, s8, v4
    s_waitcnt lgkmcnt(0)
    s_barrier
    s_mov_b32 s80, s30
    s_mov_b32 s81, s31
    s_mov_b32 s64, s32
    s_mov_b32 s65, s33
    s_mov_b32 s56, s24
    s_mov_b32 s57, s25
    s_mul_i32 s24, s2, 20736
    s_lshl_b32 s8, s3, 7
    s_add_u32 s24, s24, s8
    s_add_u32 s25, s24, 9216
    s_add_u32 s26, s25, 9216
    s_lshl_b32 s27, s4, 8
    s_lshl_b32 s9, s5, 4
    s_add_u32 s27, s27, s9
    s_mul_i32 s27, s27, 1152
    s_add_u32 s27, s27, s8
    s_add_u32 s28, s27, 1152
    v_lshlrev_b32 v1, 1, v0
    v_cmp_gt_u32 vcc, 18, v0
    v_mov_b32 v2, 0x80000000
    s_nop 0
    v_cndmask_b32 v1, v2, v1, vcc
    s_mul_i32 s8, s2, 36
    buffer_load_ushort v156, v1, s[80:83], s8 offen
    s_waitcnt vmcnt(8)
    s_mov_b32 s12, 0x01000100
    s_mov_b32 s13, 0x03020302
    v_perm_b32 v1, v148, v148, s12
    v_perm_b32 v2, v148, v148, s13
    v_and_b32 v116, v1, v10
    v_and_b32 v117, v1, v11
    v_and_b32 v118, v1, v12
    v_and_b32 v119, v1, v13
    v_and_b32 v120, v2, v10
    v_and_b32 v121, v2, v11
    v_and_b32 v122, v2, v12
    v_and_b32 v123, v2, v13
    s_waitcnt vmcnt(7)
    v_mfma_f32_16x16x32_bf16 v[24:27], v[116:119], v[32:35], 0
    s_waitcnt vmcnt(6)
    v_mfma_f32_16x16x32_bf16 v[24:27], v[120:123], v[36:39], v[24:27]
    s_waitcnt vmcnt(5)
    v_readfirstlane_b32 s8, v149
    s_mul_i32 s96, s8, 1664525
    s_add_u32 s96, s96, 1013904223
    v_mov_b32 v22, s96
    s_mov_b32 exec_lo, 0xff00ff
    s_mov_b32 exec_hi, 0xff00ff00
    s_nop 0
    ds_write_b128 v20, v[24:27] offset:0
    s_mov_b32 exec_lo, 0x1
    s_mov_b32 exec_hi, 0x0
    ds_write_b32 v23, v22 offset:12816
    s_mov_b64 exec, -1
    v_and_b32 v8, 7, v0
    v_lshlrev_b32 v8, 2, v8
    s_mov_b32 s97, 0x100000
L_aw_15:
    ds_read_b32 v9, v8 offset:14208
    s_waitcnt lgkmcnt(0)
    v_cmp_eq_u32 vcc, 1, v9
    s_cmp_eq_u64 vcc, -1
    s_cbranch_scc1 L_awok_16
    s_sub_u32 s97, s97, 1
    s_cmp_eq_u32 s97, 0
    s_cbranch_scc0 L_aw_15
L_awok_16:
    v_lshlrev_b32 v1, 2, v0
    ds_read2st64_b32 v[116:117], v1 offset0:0 offset1:1
    ds_read2st64_b32 v[118:119], v1 offset0:2 offset1:3
    ds_read2st64_b32 v[120:121], v1 offset0:4 offset1:5
    ds_read2st64_b32 v[122:123], v1 offset0:6 offset1:7
    ds_read2st64_b32 v[124:125], v1 offset0:8 offset1:9
    ds_read2st64_b32 v[126:127], v1 offset0:10 offset1:11
    ds_read2st64_b32 v[128:129], v1 offset0:12 offset1:13
    ds_read2st64_b32 v[130:131], v1 offset0:14 offset1:15
    ds_read2st64_b32 v[132:133], v1 offset0:16 offset1:17
    s_waitcnt lgkmcnt(0)
    v_add_f32 v116, v116, v117
    v_add_f32 v118, v118, v119
    v_add_f32 v120, v120, v121
    v_add_f32 v122, v122, v123
    v_add_f32 v124, v124, v125
    v_add_f32 v126, v126, v127
    v_add_f32 v128, v128, v129
    v_add_f32 v130, v130, v131
    v_add_f32 v132, v132, v133
    v_add_f32 v116, v116, v118
    v_add_f32 v120, v120, v122
    v_add_f32 v124, v124, v126
    v_add_f32 v128, v128, v130
    v_add_f32 v116, v116, v120
    v_add_f32 v124, v124, v128
    v_add_f32 v116, v116, v124
    v_add_f32 v116, v116, v132
    v_mov_b32 v4, v116
    s_getreg_b32 s20, hwreg(HW_REG_XCC_ID, 0, 4)
    v_and_b32 v4, 0xfffffff0, v4
    v_or_b32 v152, s20, v4
    v_mov_b32 v153, v22
    v_lshlrev_b32 v3, 3, v0
    s_lshl_b32 s8, s4, 13
    s_lshl_b32 s9, s6, 11
    s_add_u32 s8, s8, s9
    s_lshl_b32 s9, s7, 9
    s_add_u32 s8, s8, s9
    s_add_u32 s22, s8, 0x10000
    s_add_u32 s8, s8, 0x110000
    buffer_store_dwordx2 v[152:153], v3, s[68:71], s8 offen
    s_mov_b32 s29, 0
    s_waitcnt vmcnt(2)
    s_mov_b32 s16, 0x3f803f80
    v_dot2_f32_bf16 v1, v52, s16, 0
    v_dot2_f32_bf16 v2, v52, v52, 0
    v_dot2_f32_bf16 v6, v52, v60, 0
    v_dot2_f32_bf16 v1, v53, s16, v1
    v_dot2_f32_bf16 v2, v53, v53, v2
    v_dot2_f32_bf16 v6, v53, v61, v6
    v_dot2_f32_bf16 v1, v54, s16, v1
    v_dot2_f32_bf16 v2, v54, v54, v2
    v_dot2_f32_bf16 v6, v54, v62, v6
    v_dot2_f32_bf16 v1, v55, s16, v1
    v_dot2_f32_bf16 v2, v55, v55, v2
    v_dot2_f32_bf16 v6, v55, v63, v6
    v_dot2_f32_bf16 v1, v56, s16, v1
    v_dot2_f32_bf16 v2, v56, v56, v2
    v_dot2_f32_bf16 v6, v56, v64, v6
    v_dot2_f32_bf16 v1, v57, s16, v1
    v_dot2_f32_bf16 v2, v57, v57, v2
    v_dot2_f32_bf16 v6, v57, v65, v6
    v_dot2_f32_bf16 v1, v58, s16, v1
    v_dot2_f32_bf16 v2, v58, v58, v2
    v_dot2_f32_bf16 v6, v58, v66, v6
    v_dot2_f32_bf16 v1, v59, s16, v1
    v_dot2_f32_bf16 v2, v59, v59, v2
    v_dot2_f32_bf16 v6, v59, v67, v6
    s_nop 1
    v_permlane32_swap_b32 v1, v2
    v_add_f32 v1, v1, v2
    v_mov_b32 v7, v6
    s_nop 1
    v_permlane32_swap_b32 v6, v7
    v_add_f32 v6, v6, v7
    s_nop 1
    v_permlane16_swap_b32 v1, v6
    v_add_f32 v1, v1, v6
    s_nop 1
    v_add_f32_dpp v1, v1, v1 row_ror:8 row_mask:0xf bank_mask:0xf
    s_nop 1
    v_add_f32_dpp v1, v1, v1 row_ror:4 row_mask:0xf bank_mask:0xf
    s_nop 1
    v_add_f32_dpp v1, v1, v1 row_ror:2 row_mask:0xf bank_mask:0xf
    s_nop 1
    v_add_f32_dpp v1, v1, v1 row_ror:1 row_mask:0xf bank_mask:0xf
    s_nop 0
    v_readlane_b32 s16, v1, 0
    v_readlane_b32 s17, v1, 16
    v_readlane_b32 s18, v1, 32
    s_mov_b32 s19, 0x3ae38e39
    v_mov_b32 v1, s16
    v_mul_f32 v28, s19, v1
    v_mov_b32 v2, s18
    v_mul_f32 v2, s19, v2
    v_fma_f32 v2, -v28, v28, v2
    v_max_f32 v2, 0, v2
    v_add_f32 v2, 0x3727c5ac, v2
    v_rsq_f32 v29, v2
    v_mov_b32 v6, s17
    v_mul_f32 v6, 0xbfb8aa3b, v6
    v_exp_f32 v6, v6
    s_nop 0
    v_add_f32 v6, 1.0, v6
    v_rcp_f32 v30, v6
    s_nop 0
    v_sub_f32 v31, 1.0, v30
    s_mov_b32 exec_lo, 0x1
    s_mov_b32 exec_hi, 0x0
    ds_write_b128 v23, v[28:31] offset:12800
    s_mov_b64 exec, -1
    v_and_b32 v8, 7, v0
    v_lshlrev_b32 v8, 2, v8
    s_mov_b32 s97, 0x100000
L_aw_17:
    ds_read_b32 v9, v8 offset:14240
    s_waitcnt lgkmcnt(0)
    v_cmp_eq_u32 vcc, 1, v9
    s_cmp_eq_u64 vcc, -1
    s_cbranch_scc1 L_awok_18
    s_sub_u32 s97, s97, 1
    s_cmp_eq_u32 s97, 0
    s_cbranch_scc0 L_aw_17
L_awok_18:
    s_cmp_lt_u32 s95, 3
    s_cbranch_scc0 L_nohs
    v_lshlrev_b32 v1, 2, v0
    ds_read2st64_b32 v[116:117], v1 offset0:18 offset1:19
    ds_read2st64_b32 v[118:119], v1 offset0:20 offset1:21
    ds_read2st64_b32 v[120:121], v1 offset0:22 offset1:23
    ds_read2st64_b32 v[122:123], v1 offset0:24 offset1:25
    ds_read2st64_b32 v[124:125], v1 offset0:26 offset1:27
    ds_read2st64_b32 v[126:127], v1 offset0:28 offset1:29
    ds_read2st64_b32 v[128:129], v1 offset0:30 offset1:31
    ds_read2st64_b32 v[130:131], v1 offset0:32 offset1:33
    s_waitcnt lgkmcnt(0)
    v_add_f32 v116, v116, v117
    v_add_f32 v118, v118, v119
    v_add_f32 v120, v120, v121
    v_add_f32 v122, v122, v123
    v_add_f32 v124, v124, v125
    v_add_f32 v126, v126, v127
    v_add_f32 v128, v128, v129
    v_add_f32 v130, v130, v131
    v_add_f32 v116, v116, v118
    v_add_f32 v120, v120, v122
    v_add_f32 v124, v124, v126
    v_add_f32 v128, v128, v130
    v_add_f32 v116, v116, v120
    v_add_f32 v124, v124, v128
    v_add_f32 v116, v116, v124
    v_mov_b32 v6, v116
    v_lshlrev_b32 v1, 2, v0
    ds_read2st64_b32 v[116:117], v1 offset0:34 offset1:35
    ds_read2st64_b32 v[118:119], v1 offset0:36 offset1:37
    ds_read2st64_b32 v[120:121], v1 offset0:38 offset1:39
    ds_read2st64_b32 v[122:123], v1 offset0:40 offset1:41
    ds_read2st64_b32 v[124:125], v1 offset0:42 offset1:43
    ds_read2st64_b32 v[126:127], v1 offset0:44 offset1:45
    ds_read2st64_b32 v[128:129], v1 offset0:46 offset1:47
    ds_read2st64_b32 v[130:131], v1 offset0:48 offset1:49
    s_waitcnt lgkmcnt(0)
    v_add_f32 v116, v116, v117
    v_add_f32 v118, v118, v119
    v_add_f32 v120, v120, v121
    v_add_f32 v122, v122, v123
    v_add_f32 v124, v124, v125
    v_add_f32 v126, v126, v127
    v_add_f32 v128, v128, v129
    v_add_f32 v130, v130, v131
    v_add_f32 v116, v116, v118
    v_add_f32 v120, v120, v122
    v_add_f32 v124, v124, v126
    v_add_f32 v128, v128, v130
    v_add_f32 v116, v116, v120
    v_add_f32 v124, v124, v128
    v_add_f32 v116, v116, v124
    v_mov_b32 v7, v116
    v_fma_f32 v6, -v28, v7, v6
    v_mul_f32 v6, v6, v29
    v_mov_b32 v7, v22
    s_mul_i32 s8, s95, 36864
    s_lshl_b32 s9, s15, 9
    s_add_u32 s8, s8, s9
    s_add_u32 s8, s8, 0x40000
    buffer_store_dwordx2 v[6:7], v3, s[68:71], s8 offen sc1
L_nohs:
    s_add_u32 s8, s96, 1
    v_mov_b32 v84, s8
    v_mov_b32 v85, s8
    v_mov_b32 v86, s8
    v_mov_b32 v87, s8
    s_lshl_b32 s16, s4, 13
    s_add_u32 s16, s16, 0x110000
    s_add_u32 s17, s16, 2048
    s_add_u32 s18, s16, 4096
    s_add_u32 s19, s16, 6144
    v_mov_b32 v8, 0
    s_mov_b32 s97, 0x100000
L_aw_19:
    ds_read_b32 v9, v8 offset:14344
    s_waitcnt lgkmcnt(0)
    v_cmp_eq_u32 vcc, 1, v9
    s_cmp_eq_u64 vcc, -1
    s_cbranch_scc1 L_awok_20
    s_sub_u32 s97, s97, 1
    s_cmp_eq_u32 s97, 0
    s_cbranch_scc0 L_aw_19
L_awok_20:
    buffer_load_dwordx4 v[84:87], v19, s[68:71], s16 offen offset:0 sc1
    buffer_load_dwordx4 v[88:91], v19, s[68:71], s16 offen offset:1024 sc1
    buffer_load_dwordx4 v[92:95], v19, s[68:71], s17 offen offset:0 sc1
    buffer_load_dwordx4 v[96:99], v19, s[68:71], s17 offen offset:1024 sc1
    buffer_load_dwordx4 v[100:103], v19, s[68:71], s18 offen offset:0 sc1
    buffer_load_dwordx4 v[104:107], v19, s[68:71], s18 offen offset:1024 sc1
    buffer_load_dwordx4 v[108:111], v19, s[68:71], s19 offen offset:0 sc1
    buffer_load_dwordx4 v[112:115], v19, s[68:71], s19 offen offset:1024 sc1
    s_mov_b32 s97, 0x40000
L_mp_21:
    s_waitcnt vmcnt(0)
    s_mov_b32 s37, 0
    s_cmp_eq_u32 s97, 262096
    s_cbranch_scc0 L_nf_23
    v_lshlrev_b32 v1, 3, v0
    buffer_store_dwordx2 v[152:153], v1, s[68:71], s22 offen sc1
    s_mov_b32 s29, 1
L_nf_23:
    s_cmp_lt_u32 s97, 262096
    s_cselect_b32 s8, 0x100000, 0
    s_xor_b32 s16, s16, s8
    s_xor_b32 s17, s17, s8
    s_xor_b32 s18, s18, s8
    s_xor_b32 s19, s19, s8
    v_cmp_ne_u32 vcc, s96, v85
    v_cmp_ne_u32 s[12:13], s96, v87
    s_or_b64 vcc, vcc, s[12:13]
    s_cbranch_scc0 L_mps_24
    s_mov_b64 exec, vcc
    buffer_load_dwordx4 v[84:87], v19, s[68:71], s16 offen offset:0 sc1
    s_mov_b64 exec, -1
    s_mov_b32 s37, 1
L_mps_24:
    v_cmp_ne_u32 vcc, s96, v89
    v_cmp_ne_u32 s[12:13], s96, v91
    s_or_b64 vcc, vcc, s[12:13]
    s_cbranch_scc0 L_mps_25
    s_mov_b64 exec, vcc
    buffer_load_dwordx4 v[88:91], v19, s[68:71], s16 offen offset:1024 sc1
    s_mov_b64 exec, -1
    s_mov_b32 s37, 1
L_mps_25:
    v_cmp_ne_u32 vcc, s96, v93
    v_cmp_ne_u32 s[12:13], s96, v95
    s_or_b64 vcc, vcc, s[12:13]
    s_cbranch_scc0 L_mps_26
    s_mov_b64 exec, vcc
    buffer_load_dwordx4 v[92:95], v19, s[68:71], s17 offen offset:0 sc1
    s_mov_b64 exec, -1
    s_mov_b32 s37, 1
L_mps_26:
    v_cmp_ne_u32 vcc, s96, v97
    v_cmp_ne_u32 s[12:13], s96, v99
    s_or_b64 vcc, vcc, s[12:13]
    s_cbranch_scc0 L_mps_27
    s_mov_b64 exec, vcc
    buffer_load_dwordx4 v[96:99], v19, s[68:71], s17 offen offset:1024 sc1
    s_mov_b64 exec, -1
    s_mov_b32 s37, 1
L_mps_27:
    v_cmp_ne_u32 vcc, s96, v101
    v_cmp_ne_u32 s[12:13], s96, v103
    s_or_b64 vcc, vcc, s[12:13]
    s_cbranch_scc0 L_mps_28
    s_mov_b64 exec, vcc
    buffer_load_dwordx4 v[100:103], v19, s[68:71], s18 offen offset:0 sc1
    s_mov_b64 exec, -1
    s_mov_b32 s37, 1
L_mps_28:
    v_cmp_ne_u32 vcc, s96, v105
    v_cmp_ne_u32 s[12:13], s96, v107
    s_or_b64 vcc, vcc, s[12:13]
    s_cbranch_scc0 L_mps_29
    s_mov_b64 exec, vcc
    buffer_load_dwordx4 v[104:107], v19, s[68:71], s18 offen offset:1024 sc1
    s_mov_b64 exec, -1
    s_mov_b32 s37, 1
L_mps_29:
    v_cmp_ne_u32 vcc, s96, v109
    v_cmp_ne_u32 s[12:13], s96, v111
    s_or_b64 vcc, vcc, s[12:13]
    s_cbranch_scc0 L_mps_30
    s_mov_b64 exec, vcc
    buffer_load_dwordx4 v[108:111], v19, s[68:71], s19 offen offset:0 sc1
    s_mov_b64 exec, -1
    s_mov_b32 s37, 1
L_mps_30:
    v_cmp_ne_u32 vcc, s96, v113
    v_cmp_ne_u32 s[12:13], s96, v115
    s_or_b64 vcc, vcc, s[12:13]
    s_cbranch_scc0 L_mps_31
    s_mov_b64 exec, vcc
    buffer_load_dwordx4 v[112:115], v19, s[68:71], s19 offen offset:1024 sc1
    s_mov_b64 exec, -1
    s_mov_b32 s37, 1
L_mps_31:
    s_cmp_eq_u32 s37, 0
    s_cbranch_scc1 L_mpok_22
    s_sub_u32 s97, s97, 1
    s_cmp_eq_u32 s97, 0
    s_cbranch_scc0 L_mp_21
    s_waitcnt vmcnt(0)
L_mpok_22:
    v_xor_b32 v1, s20, v84
    v_xor_b32 v2, s20, v88
    v_or_b32 v1, v1, v2
    v_xor_b32 v2, s20, v92
    v_or_b32 v1, v1, v2
    v_xor_b32 v2, s20, v96
    v_or_b32 v1, v1, v2
    v_xor_b32 v2, s20, v100
    v_or_b32 v1, v1, v2
    v_xor_b32 v2, s20, v104
    v_or_b32 v1, v1, v2
    v_xor_b32 v2, s20, v108
    v_or_b32 v1, v1, v2
    v_xor_b32 v2, s20, v112
    v_or_b32 v1, v1, v2
    v_and_b32 v1, 15, v1
    v_cmp_ne_u32 vcc, 0, v1
    s_cmp_eq_u64 vcc, 0
    s_cselect_b32 s21, 0, 0x100000
    s_cbranch_scc1 L_qlocal
    s_cmp_eq_u32 s29, 0
    s_cbranch_scc0 L_qlocal
    v_lshlrev_b32 v1, 3, v0
    buffer_store_dwordx2 v[152:153], v1, s[68:71], s22 offen sc1
    s_mov_b32 s29, 1
L_qlocal:
    v_mov_b32 v1, s21
    s_mov_b32 exec_lo, 0x1
    s_mov_b32 exec_hi, 0x0
    ds_write_b32 v23, v1 offset:12820
    s_mov_b64 exec, -1
    v_and_b32 v84, 0xfffffff0, v84
    v_and_b32 v86, 0xfffffff0, v86
    v_and_b32 v88, 0xfffffff0, v88
    v_and_b32 v90, 0xfffffff0, v90
    v_and_b32 v92, 0xfffffff0, v92
    v_and_b32 v94, 0xfffffff0, v94
    v_and_b32 v96, 0xfffffff0, v96
    v_and_b32 v98, 0xfffffff0, v98
    v_and_b32 v100, 0xfffffff0, v100
    v_and_b32 v102, 0xfffffff0, v102
    v_and_b32 v104, 0xfffffff0, v104
    v_and_b32 v106, 0xfffffff0, v106
    v_and_b32 v108, 0xfffffff0, v108
    v_and_b32 v110, 0xfffffff0, v110
    v_and_b32 v112, 0xfffffff0, v112
    v_and_b32 v114, 0xfffffff0, v114
    v_add_f32 v84, v84, v92
    v_add_f32 v100, v100, v108
    v_add_f32 v84, v84, v100
    v_add_f32 v86, v86, v94
    v_add_f32 v102, v102, v110
    v_add_f32 v86, v86, v102
    v_add_f32 v88, v88, v96
    v_add_f32 v104, v104, v112
    v_add_f32 v88, v88, v104
    v_add_f32 v90, v90, v98
    v_add_f32 v106, v106, v114
    v_add_f32 v90, v90, v106
    v_cvt_pk_bf16_f32 v1, v84, v86
    v_cvt_pk_bf16_f32 v2, v88, v90
    v_lshlrev_b32 v4, 2, v0
    ds_write_b32 v4, v1 offset:12864
    ds_write_b32 v4, v2 offset:13120
    v_mov_b32 v8, 0
    v_mov_b32 v9, 1
    s_mov_b32 exec_lo, 0x1
    s_mov_b32 exec_hi, 0x0
    ds_write_b32 v8, v9 offset:14336
    s_mov_b64 exec, -1
    buffer_load_dwordx4 v[40:43], v16, s[64:67], s24 offen nt
    buffer_load_dwordx4 v[44:47], v16, s[64:67], s25 offen nt
    buffer_load_dwordx4 v[48:51], v17, s[64:67], s26 offen nt
    buffer_load_dwordx4 v[32:35], v164, s[56:59], s27 offen nt
    buffer_load_dwordx4 v[36:39], v164, s[56:59], s28 offen nt
    v_lshlrev_b32 v155, 3, v0
    s_mul_i32 s16, s2, 144
    s_add_u32 s16, s16, 0x40000
    s_add_u32 s17, s16, 36864
    s_add_u32 s18, s17, 36864
    v_and_b32 v8, 7, v0
    v_lshlrev_b32 v8, 2, v8
    s_mov_b32 s97, 0x100000
L_aw_32:
    ds_read_b32 v9, v8 offset:14272
    s_waitcnt lgkmcnt(0)
    v_cmp_eq_u32 vcc, 1, v9
    s_cmp_eq_u64 vcc, -1
    s_cbranch_scc1 L_awok_33
    s_sub_u32 s97, s97, 1
    s_cmp_eq_u32 s97, 0
    s_cbranch_scc0 L_aw_32
L_awok_33:
    v_mov_b32 v52, 0
    v_mov_b32 v53, 0
    v_mov_b32 v54, 0
    v_mov_b32 v55, 0
    v_mov_b32 v56, 0
    v_mov_b32 v57, 0
    s_mov_b32 exec_lo, 0x3ffff
    s_mov_b32 exec_hi, 0x0
    buffer_load_dwordx2 v[52:53], v155, s[68:71], s16 offen sc1
    buffer_load_dwordx2 v[54:55], v155, s[68:71], s17 offen sc1
    buffer_load_dwordx2 v[56:57], v155, s[68:71], s18 offen sc1
    s_mov_b64 exec, -1
    s_mov_b32 s97, 0x40000
L_mp_34:
    s_waitcnt vmcnt(0)
    s_mov_b32 s37, 0
    v_cmp_ne_u32 vcc, s96, v53
    s_mov_b32 s12, 0x3ffff
    s_mov_b32 s13, 0x0
    s_and_b64 vcc, vcc, s[12:13]
    s_cbranch_scc0 L_mps_36
    s_mov_b64 exec, vcc
    buffer_load_dwordx2 v[52:53], v155, s[68:71], s16 offen sc1
    s_mov_b64 exec, -1
    s_mov_b32 s37, 1
L_mps_36:
    v_cmp_ne_u32 vcc, s96, v55
    s_mov_b32 s12, 0x3ffff
    s_mov_b32 s13, 0x0
    s_and_b64 vcc, vcc, s[12:13]
    s_cbranch_scc0 L_mps_37
    s_mov_b64 exec, vcc
    buffer_load_dwordx2 v[54:55], v155, s[68:71], s17 offen sc1
    s_mov_b64 exec, -1
    s_mov_b32 s37, 1
L_mps_37:
    v_cmp_ne_u32 vcc, s96, v57
    s_mov_b32 s12, 0x3ffff
    s_mov_b32 s13, 0x0
    s_and_b64 vcc, vcc, s[12:13]
    s_cbranch_scc0 L_mps_38
    s_mov_b64 exec, vcc
    buffer_load_dwordx2 v[56:57], v155, s[68:71], s18 offen sc1
    s_mov_b64 exec, -1
    s_mov_b32 s37, 1
L_mps_38:
    s_cmp_eq_u32 s37, 0
    s_cbranch_scc1 L_mpok_35
    s_sub_u32 s97, s97, 1
    s_cmp_eq_u32 s97, 0
    s_cbranch_scc0 L_mp_34
    s_waitcnt vmcnt(0)
L_mpok_35:
    v_add_f32 v1, v52, v54
    v_add_f32 v1, v1, v56
    v_lshlrev_b32 v2, 16, v156
    v_add_f32 v1, v1, v2
    v_mul_f32 v2, v1, v1
    v_mov_b32 v3, 0xc0135761
    v_fmac_f32 v3, 0xbdd2d3e8, v2
    v_mul_f32 v3, v3, v1
    v_exp_f32 v3, v3
    s_nop 0
    v_add_f32 v3, 1.0, v3
    v_rcp_f32 v3, v3
    s_nop 0
    v_mul_f32 v1, v1, v3
    v_mul_f32 v1, v1, v31
    v_cvt_pk_bf16_f32 v1, v1, v1
    v_lshlrev_b32 v2, 2, v0
    s_mov_b32 exec_lo, 0xffffff
    s_mov_b32 exec_hi, 0x0
    ds_write_b32 v2, v1 offset:13504
    s_mov_b64 exec, -1
    v_mov_b32 v8, 0
    v_mov_b32 v9, 1
    s_mov_b32 exec_lo, 0x1
    s_mov_b32 exec_hi, 0x0
    ds_write_b32 v8, v9 offset:14340
    s_mov_b64 exec, -1
    v_lshlrev_b32 v6, 2, v21
    ds_read_b32 v1, v6 offset:13504
    ds_read_b32 v2, v6 offset:13536
    ds_read_b32 v3, v6 offset:13568
    s_waitcnt lgkmcnt(0)
    v_and_b32 v52, v1, v10
    v_and_b32 v53, v1, v11
    v_and_b32 v54, v1, v12
    v_and_b32 v55, v1, v13
    v_and_b32 v56, v2, v10
    v_and_b32 v57, v2, v11
    v_and_b32 v58, v2, v12
    v_and_b32 v59, v2, v13
    v_and_b32 v60, v3, v10
    v_and_b32 v61, v3, v11
    v_and_b32 v62, v3, v12
    v_and_b32 v63, v3, v13
    v_and_b32 v1, 7, v0
    v_lshlrev_b32 v1, 5, v1
    v_bfe_u32 v2, v0, 4, 1
    v_lshl_add_u32 v1, v2, 4, v1
    v_lshrrev_b32 v2, 5, v0
    v_lshl_add_u32 v157, v2, 3, v1
    s_mul_i32 s34, s2, 2432
    s_lshl_b32 s9, s3, 8
    s_add_u32 s34, s34, s9
    s_add_u32 s34, s34, 0x200000
    v_lshrrev_b32 v1, 2, v0
    v_lshlrev_b32 v155, 7, v1
    v_and_b32 v2, 3, v0
    v_lshlrev_b32 v2, 4, v2
    v_lshl_add_u32 v156, v1, 10, v2
    s_lshl_b32 s30, s4, 14
    s_lshl_b32 s8, s5, 6
    s_add_u32 s30, s30, s8
    s_add_u32 s30, s30, 0x180000
    s_lshl_b32 s32, s4, 11
    s_lshr_b32 s8, s5, 3
    s_lshl_b32 s8, s8, 4
    s_add_u32 s32, s32, s8
    s_add_u32 s32, s32, 0x130000
    v_and_b32 v1, 1, v0
    v_lshlrev_b32 v152, 5, v1
    v_lshlrev_b32 v153, 4, v0
    s_lshl_b32 s35, s4, 4
    s_add_u32 s35, s35, s5
    s_lshl_b32 s35, s35, 7
    s_add_u32 s36, s35, 0x130000
    s_add_u32 s35, s35, 0x30000
    s_lshl_b32 s8, s5, 2
    s_mov_b32 s40, 15
    s_mov_b32 s41, 0
    s_lshl_b64 s[40:41], s[40:41], s8
    s_not_b64 s[38:39], s[40:41]
    v_lshlrev_b32 v20, 3, v21
    s_lshl_b32 s9, s5, 6
    v_add_u32 v14, s9, v2
    s_lshr_b32 s33, s5, 1
    s_lshl_b32 s33, s33, 2
    v_bfe_u32 v1, v0, 4, 1
    v_lshl_add_u32 v1, v1, 3, v2
    v_lshrrev_b32 v3, 5, v0
    v_lshl_add_u32 v15, v3, 2, v1
    v_mfma_f32_16x16x32_bf16 v[160:163], v[52:55], v[40:43], 0
    v_mfma_f32_16x16x32_bf16 v[160:163], v[56:59], v[44:47], v[160:163]
    v_mfma_f32_16x16x32_bf16 v[160:163], v[60:63], v[48:51], v[160:163]
    v_and_b32 v8, 7, v0
    v_lshlrev_b32 v8, 2, v8
    s_mov_b32 s97, 0x100000
L_aw_39:
    ds_read_b32 v9, v8 offset:14304
    ds_read_b128 v[116:119], v152 offset:13376
    ds_read_b128 v[120:123], v152 offset:13392
    ds_read_b128 v[124:127], v152 offset:13440
    ds_read_b128 v[128:131], v152 offset:13456
    s_waitcnt lgkmcnt(0)
    v_cmp_eq_u32 vcc, 1, v9
    s_cmp_eq_u64 vcc, -1
    s_cbranch_scc1 L_awok_40
    s_sub_u32 s97, s97, 1
    s_cmp_eq_u32 s97, 0
    s_cbranch_scc0 L_aw_39
L_awok_40:
    v_max3_f32 v4, v116, v117, v118
    v_max3_f32 v5, v119, v120, v121
    v_max3_f32 v4, v4, v122, v123
    v_max_f32 v4, v4, v5
    v_mul_f32 v148, 0x3e0293ee, v4
    v_add_f32 v124, v124, v125
    v_add_f32 v126, v126, v127
    v_add_f32 v128, v128, v129
    v_add_f32 v130, v130, v131
    v_add_f32 v124, v124, v126
    v_add_f32 v128, v128, v130
    v_add_f32 v150, v124, v128
    v_mov_b32 v149, v22
    v_mov_b32 v151, v22
    s_mov_b32 exec_lo, 0xff
    s_mov_b32 exec_hi, 0x0
    buffer_store_dwordx4 v[148:151], v153, s[68:71], s36 offen
    s_cmp_eq_u32 s21, 0
    s_cbranch_scc1 L_mllocal
    buffer_store_dwordx4 v[148:151], v153, s[68:71], s35 offen sc1
L_mllocal:
    s_mov_b64 exec, -1
    buffer_load_dwordx4 v[88:91], v155, s[68:71], s32 offen sc1
    s_mov_b32 s97, 0x40000
L_mp_41:
    s_waitcnt vmcnt(0)
    s_mov_b32 s37, 0
    s_xor_b32 s32, s32, s21
    v_cmp_ne_u32 vcc, s96, v89
    v_cmp_ne_u32 s[12:13], s96, v91
    s_or_b64 vcc, vcc, s[12:13]
    s_cbranch_scc0 L_mps_43
    s_mov_b64 exec, vcc
    buffer_load_dwordx4 v[88:91], v155, s[68:71], s32 offen sc1
    s_mov_b64 exec, -1
    s_mov_b32 s37, 1
L_mps_43:
    s_cmp_eq_u32 s37, 0
    s_cbranch_scc1 L_mpok_42
    s_sub_u32 s97, s97, 1
    s_cmp_eq_u32 s97, 0
    s_cbranch_scc0 L_mp_41
    s_waitcnt vmcnt(0)
L_mpok_42:
    buffer_load_dwordx4 v[84:87], v156, s[68:71], s30 offen sc1
    v_mov_b32 v1, v88
    s_nop 1
    v_max_f32_dpp v1, v1, v1 row_ror:4 row_mask:0xf bank_mask:0xf
    s_nop 1
    v_max_f32_dpp v1, v1, v1 row_ror:8 row_mask:0xf bank_mask:0xf
    v_mov_b32 v7, v1
    s_nop 1
    v_permlane16_swap_b32 v1, v7
    v_max_f32 v1, v1, v7
    v_mov_b32 v7, v1
    s_nop 1
    v_permlane32_swap_b32 v1, v7
    v_max_f32 v1, v1, v7
    v_sub_f32 v2, v88, v1
    v_exp_f32 v2, v2
    s_nop 0
    v_mul_f32 v6, v2, v90
    s_nop 1
    v_add_f32_dpp v6, v6, v6 row_ror:4 row_mask:0xf bank_mask:0xf
    s_nop 1
    v_add_f32_dpp v6, v6, v6 row_ror:8 row_mask:0xf bank_mask:0xf
    v_mov_b32 v7, v6
    s_nop 1
    v_permlane16_swap_b32 v6, v7
    v_add_f32 v6, v6, v7
    v_mov_b32 v7, v6
    s_nop 1
    v_permlane32_swap_b32 v6, v7
    v_add_f32 v6, v6, v7
    v_rcp_f32 v6, v6
    v_mul_f32 v2, v2, v30
    v_mul_f32 v2, v2, v6
    v_mov_b32 v8, s33
    s_mov_b32 s97, 0x40000
L_og_44:
    ds_read_b32 v9, v8 offset:14400
    ds_read_b128 v[96:99], v14 offset:22656
    s_waitcnt vmcnt(0) lgkmcnt(0)
    v_cmp_ne_u32 vcc, s96, v85
    v_cmp_ne_u32 s[12:13], s96, v87
    s_or_b64 vcc, vcc, s[12:13]
    s_and_b64 vcc, vcc, s[38:39]
    s_cbranch_scc0 L_ogt_45
    s_xor_b32 s30, s30, s21
    s_mov_b64 exec, vcc
    buffer_load_dwordx4 v[84:87], v156, s[68:71], s30 offen sc1
    s_mov_b64 exec, -1
    s_sub_u32 s97, s97, 1
    s_cmp_eq_u32 s97, 0
    s_cbranch_scc0 L_og_44
    s_waitcnt vmcnt(0)
    s_branch L_ogd_46
L_ogt_45:
    v_cmp_eq_u32 vcc, 1, v9
    s_cmp_eq_u64 vcc, -1
    s_cbranch_scc1 L_ogd_46
    s_sub_u32 s97, s97, 1
    s_cmp_eq_u32 s97, 0
    s_cbranch_scc0 L_og_44
L_ogd_46:
    v_lshlrev_b32 v92, 16, v84
    v_and_b32 v93, 0xffff0000, v84
    v_lshlrev_b32 v94, 16, v86
    v_and_b32 v95, 0xffff0000, v86
    v_cndmask_b32 v92, v92, v96, s[40:41]
    v_cndmask_b32 v93, v93, v97, s[40:41]
    v_cndmask_b32 v94, v94, v98, s[40:41]
    v_cndmask_b32 v95, v95, v99, s[40:41]
    v_mul_f32 v92, v2, v92
    v_mul_f32 v93, v2, v93
    v_mul_f32 v94, v2, v94
    v_mul_f32 v95, v2, v95
    v_permlane32_swap_b32 v92, v93
    s_nop 0
    v_permlane32_swap_b32 v94, v95
    v_add_f32 v92, v92, v93
    v_add_f32 v94, v94, v95
    s_nop 1
    v_permlane16_swap_b32 v92, v94
    v_add_f32 v4, v92, v94
    s_nop 1
    v_add_f32_dpp v4, v4, v4 row_ror:8 row_mask:0xf bank_mask:0xf
    s_nop 1
    v_add_f32_dpp v4, v4, v4 row_ror:4 row_mask:0xf bank_mask:0xf
    v_cvt_pk_bf16_f32 v4, v4, v4
    s_mov_b32 exec_lo, 0xf000f
    s_mov_b32 exec_hi, 0xf000f
    ds_write_b32 v15, v4 offset:13632
    s_mov_b64 exec, -1
    s_waitcnt lgkmcnt(0)
    s_barrier
    ds_read_b64 v[6:7], v20 offset:13632
    s_waitcnt lgkmcnt(0)
    v_and_b32 v64, v6, v10
    v_and_b32 v65, v6, v11
    v_and_b32 v66, v6, v12
    v_and_b32 v67, v6, v13
    v_and_b32 v68, v7, v10
    v_and_b32 v69, v7, v11
    v_and_b32 v70, v7, v12
    v_and_b32 v71, v7, v13
    v_mfma_f32_16x16x32_bf16 v[160:163], v[64:67], v[32:35], v[160:163]
    s_nop 0
    v_mfma_f32_16x16x32_bf16 v[160:163], v[68:71], v[36:39], v[160:163]
    s_nop 7
    v_permlane32_swap_b32 v160, v162
    v_permlane32_swap_b32 v161, v163
    s_nop 0
    v_add_f32_dpp v148, v162, v160 row_ror:8 row_mask:0x3 bank_mask:0xf
    v_add_f32_dpp v150, v163, v161 row_ror:8 row_mask:0x3 bank_mask:0xf
    s_nop 0
    v_add_f32_dpp v148, v160, v162 row_ror:8 row_mask:0xc bank_mask:0xf
    v_add_f32_dpp v150, v161, v163 row_ror:8 row_mask:0xc bank_mask:0xf
    s_mov_b32 exec_lo, 0xff00ff
    s_mov_b32 exec_hi, 0xff00ff00
    v_cvt_pk_bf16_f32 v148, v148, v150
    buffer_store_dwordx2 v[148:149], v157, s[68:71], s34 offen sc1
    s_mov_b64 exec, -1
    s_cmp_lt_u32 s2, 238
    s_cbranch_scc1 L_done
    s_waitcnt lgkmcnt(0)
    s_barrier
L_done:
L_end:
    s_endpgm
.section .rodata,"a"
.p2align 6
.amdhsa_kernel gated_mix__sliding_block_cached__mixer_channel_mlp__decode_kernel
  .amdhsa_next_free_vgpr 168
  .amdhsa_next_free_sgpr 102
  .amdhsa_accum_offset 168
  .amdhsa_group_segment_fixed_size 0
  .amdhsa_kernarg_size 112
  .amdhsa_user_sgpr_count 2
  .amdhsa_user_sgpr_kernarg_segment_ptr 1
  .amdhsa_system_sgpr_workgroup_id_x 1
  .amdhsa_float_denorm_mode_32 3
.end_amdhsa_kernel
```
